```python
import torch

def _softmax(x, axis=-1):
    return torch.softmax(x, dim=axis)
def _gelu(x):
    return torch.nn.functional.gelu(x, approximate="tanh")
def _silu(x):
    return torch.nn.functional.silu(x)
def _sigmoid(x):
    return torch.sigmoid(x)
def _layernorm(x, axis=-1, eps=1e-5):
    m = x.mean(dim=axis, keepdim=True)
    v = x.var(dim=axis, keepdim=True, unbiased=False)
    return (x - m) / torch.sqrt(v + eps)
def _scatter_add(tgt, idx, src, axis=0):
    return tgt.clone().index_add_(axis, idx, src)
def _segment_sum(src, seg, n):
    out = torch.zeros((n,) + src.shape[1:], dtype=src.dtype)
    return out.index_add_(0, seg, src)
def _pad(x, pw):
    flat = tuple(v for pair in reversed(pw) for v in pair)
    return torch.nn.functional.pad(x, flat)

kernel_name = 'concat_heads__sliding_block_cached__sliding_block_cached__decode'

def setup_inputs():

    _w = (lambda a: (lambda t: t.to(torch.bfloat16) if t.is_floating_point() else t)(torch.as_tensor(a)))
    def _A_setup():
        B, Sq, D = 8, 1, 512
        Hq, Hkv, Sk, Dh = 32, 8, 4096, 128
        assert Hq % Hkv == 0, (Hq, Hkv)
        return {
            "x": _w((lambda *s: torch.randn(*s, dtype=torch.bfloat16) * 0.8)(B, Sq, D)),
            "k_cache": _w((lambda *s: torch.randn(*s, dtype=torch.bfloat16) * 0.8)(B, Hkv, Sk, Dh)),
            "v_cache": _w((lambda *s: torch.randn(*s, dtype=torch.bfloat16) * 0.05)(B, Hkv, Sk, Dh)),
            "wq": _w((lambda *s: torch.randn(*s, dtype=torch.bfloat16) * 0.8)(D, Hq * Dh) * (D ** -0.5)),
            "wo": _w((lambda *s: torch.randn(*s, dtype=torch.bfloat16) * 0.05)(Hq * Dh, D) * ((Hq * Dh) ** -0.5)),
        }
    _A_in = _A_setup()

    def _B_setup():
        B, Sq, D = 8, 1, 512
        Hq, Hkv, Sk, Dh = 32, 8, 4096, 128
        assert Hq % Hkv == 0, (Hq, Hkv)
        return {
            "x": _w((lambda *s: torch.randn(*s, dtype=torch.bfloat16) * 0.8)(B, Sq, D)),
            "k_cache": _w((lambda *s: torch.randn(*s, dtype=torch.bfloat16) * 0.8)(B, Hkv, Sk, Dh)),
            "v_cache": _w((lambda *s: torch.randn(*s, dtype=torch.bfloat16) * 0.05)(B, Hkv, Sk, Dh)),
            "wq": _w((lambda *s: torch.randn(*s, dtype=torch.bfloat16) * 0.8)(D, Hq * Dh) * (D ** -0.5)),
            "wo": _w((lambda *s: torch.randn(*s, dtype=torch.bfloat16) * 0.05)(Hq * Dh, D) * ((Hq * Dh) ** -0.5)),
        }
    _B_in = _B_setup()

    return {
        "A_x": _A_in["x"],
        "A_k_cache": _A_in["k_cache"],
        "A_v_cache": _A_in["v_cache"],
        "A_wq": _A_in["wq"],
        "A_wo": _A_in["wo"],
        "B_x": _B_in["x"],
        "B_k_cache": _B_in["k_cache"],
        "B_v_cache": _B_in["v_cache"],
        "B_wq": _B_in["wq"],
        "B_wo": _B_in["wo"],
    }

def reference(A_x, A_k_cache, A_v_cache, A_wq, A_wo, B_x, B_k_cache, B_v_cache, B_wq, B_wo):
    def _A_ref(x, k_cache, v_cache, wq, wo):
        B, Sq, D = x.shape
        Hq, Dh = 32, 128
        Hkv, Sk = k_cache.shape[1], k_cache.shape[2]
        W = min(4096, max(256, Sk // 4))
        rep = Hq // Hkv
        q = (lambda x, *d: x.permute(*d))((x @ wq).reshape(B, Sq, Hq, Dh), 0, 2, 1, 3)
        k = (lambda x, n, axis: torch.repeat_interleave(x, n, dim=axis))(k_cache[:, :, Sk - W:, :], rep, axis=1)
        v = (lambda x, n, axis: torch.repeat_interleave(x, n, dim=axis))(v_cache[:, :, Sk - W:, :], rep, axis=1)
        scores = torch.einsum("bhqd,bhkd->bhqk", q, k) * (Dh ** -0.5)
        p = _softmax(scores, axis=-1)
        o = torch.einsum("bhqk,bhkd->bhqd", p, v)
        return (lambda x, *d: x.permute(*d))(o, 0, 2, 1, 3).reshape(B, Sq, Hq * Dh) @ wo

    def _B_ref(x, k_cache, v_cache, wq, wo):
        B, Sq, D = x.shape
        Hq, Dh = 32, 128
        Hkv, Sk = k_cache.shape[1], k_cache.shape[2]
        W = min(4096, max(256, Sk // 4))
        rep = Hq // Hkv
        q = (lambda x, *d: x.permute(*d))((x @ wq).reshape(B, Sq, Hq, Dh), 0, 2, 1, 3)
        k = (lambda x, n, axis: torch.repeat_interleave(x, n, dim=axis))(k_cache[:, :, Sk - W:, :], rep, axis=1)
        v = (lambda x, n, axis: torch.repeat_interleave(x, n, dim=axis))(v_cache[:, :, Sk - W:, :], rep, axis=1)
        scores = torch.einsum("bhqd,bhkd->bhqk", q, k) * (Dh ** -0.5)
        p = _softmax(scores, axis=-1)
        o = torch.einsum("bhqk,bhkd->bhqd", p, v)
        return (lambda x, *d: x.permute(*d))(o, 0, 2, 1, 3).reshape(B, Sq, Hq * Dh) @ wo

    a = _A_ref(A_x, A_k_cache, A_v_cache, A_wq, A_wo)
    b = _B_ref(B_x, B_k_cache, B_v_cache, B_wq, B_wo)
    return torch.concatenate([a, b], axis=-1)
```

```asm
; @launch grid=(256,1,1) block=(768,1,1) lds=37440
.amdgcn_target "amdgcn-amd-amdhsa--gfx950"
.text
.globl concat_heads__sliding_block_cached__sliding_block_cached__decode_kernel
.p2align 8
.type concat_heads__sliding_block_cached__sliding_block_cached__decode_kernel,@function
concat_heads__sliding_block_cached__sliding_block_cached__decode_kernel:
    s_cmp_ge_u32 s2, 256
    s_cbranch_scc1 L_end
    s_and_b32 s3, s2, 7
    s_lshl_b32 s3, s3, 1
    s_lshr_b32 s4, s2, 7
    s_add_u32 s92, s3, s4
    s_lshr_b32 s3, s92, 3
    s_mul_i32 s4, s3, 40
    s_add_u32 s4, s0, s4
    s_addc_u32 s5, s1, 0
    s_load_dwordx8 s[8:15], s[4:5], 0
    s_load_dwordx2 s[16:17], s[4:5], 32
    s_load_dwordx4 s[20:23], s[0:1], 80
    s_load_dwordx2 s[24:25], s[0:1], 96
    s_bfe_u32 s4, s2, 0x40003
    s_and_b32 s5, s92, 7
    s_lshl_b32 s92, s92, 4
    s_add_u32 s92, s92, s4
    s_lshr_b32 s93, s4, 1
    s_lshl_b32 s93, s93, 3
    s_add_u32 s93, s93, s5
    s_lshl_b32 s93, s93, 1
    s_and_b32 s4, s4, 1
    s_add_u32 s93, s93, s4
    s_lshl_b32 s4, s3, 7
    s_add_u32 s93, s93, s4
    v_lshrrev_b32 v1, 6, v0
    v_mov_b32 v2, 0
    v_readfirstlane_b32 s6, v1
    v_and_b32 v1, 63, v0
    s_and_b32 s26, s92, 127
    s_and_b32 s94, s93, 127
    v_lshrrev_b32 v4, 4, v1
    s_mov_b64 s[96:97], -1
    s_cmp_lt_u32 s6, 4
    s_cbranch_scc0 L_att
    v_mov_b32 v8, 0
    v_mov_b32 v9, 0
    v_mov_b32 v10, 0
    v_mov_b32 v11, 0
    s_cmp_lg_u32 s6, 0
    s_cbranch_scc1 L_noinit
    ds_write_b128 v2, v[8:11]
    ds_write_b128 v2, v[8:11] offset:16
    ds_write_b128 v2, v[8:11] offset:48
L_noinit:
    s_lshr_b32 s27, s26, 2
    s_and_b32 s52, s26, 3
    v_and_b32 v5, 15, v1
    v_and_b32 v2, 7, v1
    v_lshlrev_b32 v2, 10, v2
    v_lshl_add_u32 v2, v4, 4, v2
    s_lshl_b32 s53, s52, 7
    s_lshl_b32 s54, s6, 5
    s_add_u32 s53, s53, s54
    s_lshl_b32 s54, s53, 1
    v_lshlrev_b32 v3, 16, v4
    v_lshl_add_u32 v3, v5, 4, v3
    s_lshl_b32 s56, s53, 13
    s_lshl_b32 s55, s27, 8
    s_add_u32 s56, s56, s55
    s_waitcnt lgkmcnt(0)
    s_mov_b32 s32, s14
    s_and_b32 s33, s15, 0xffff
    s_mov_b32 s34, 4194304
    s_mov_b32 s35, 0x20000
    s_mov_b32 s28, s8
    s_and_b32 s29, s9, 0xffff
    s_mov_b32 s30, 8192
    s_mov_b32 s31, 0x20000
    buffer_load_dwordx4 v[8:11], v3, s[32:35], s56 offen nt
    s_add_u32 s56, s56, 8192
    buffer_load_dwordx4 v[12:15], v3, s[32:35], s56 offen nt
    s_add_u32 s56, s56, 8192
    buffer_load_dwordx4 v[16:19], v3, s[32:35], s56 offen nt
    s_add_u32 s56, s56, 8192
    buffer_load_dwordx4 v[20:23], v3, s[32:35], s56 offen nt
    s_add_u32 s56, s56, 8192
    buffer_load_dwordx4 v[24:27], v3, s[32:35], s56 offen nt
    s_add_u32 s56, s56, 8192
    buffer_load_dwordx4 v[28:31], v3, s[32:35], s56 offen nt
    s_add_u32 s56, s56, 8192
    buffer_load_dwordx4 v[32:35], v3, s[32:35], s56 offen nt
    s_add_u32 s56, s56, 8192
    buffer_load_dwordx4 v[36:39], v3, s[32:35], s56 offen nt
    buffer_load_dwordx4 v[40:43], v2, s[28:31], s54 offen
    s_mov_b32 s36, s16
    s_and_b32 s37, s17, 0xffff
    s_mov_b32 s38, 4194304
    s_mov_b32 s39, 0x20000
    s_mov_b32 s44, s20
    s_and_b32 s45, s21, 0xffff
    s_mov_b32 s46, 16384
    s_mov_b32 s47, 0x20000
    s_mov_b32 s48, s24
    s_and_b32 s49, s25, 0xffff
    s_mov_b32 s50, 285229056
    s_mov_b32 s51, 0x20000
    s_barrier
    s_branch L_helper
L_att:
    s_sub_u32 s7, s6, 4
    s_lshr_b32 s36, s94, 1
    s_lshl_b32 s36, s36, 20
    s_and_b32 s37, s94, 1
    s_lshl_b32 s37, s37, 17
    s_add_u32 s36, s36, s37
    s_lshl_b32 s37, s7, 14
    s_add_u32 s36, s36, s37
    s_add_u32 s36, s36, 786432
    s_add_u32 s37, s36, 4096
    s_add_u32 s38, s36, 8192
    s_add_u32 s39, s36, 12288
    v_and_b32 v2, 3, v1
    v_lshlrev_b32 v2, 10, v2
    v_bfe_u32 v3, v1, 2, 2
    v_lshl_add_u32 v2, v3, 8, v2
    v_lshl_add_u32 v2, v4, 4, v2
    v_lshlrev_b32 v3, 4, v1
    s_waitcnt lgkmcnt(0)
    s_mov_b32 s28, s10
    s_and_b32 s29, s11, 0xffff
    s_mov_b32 s30, 67108864
    s_mov_b32 s31, 0x20000
    s_mov_b32 s32, s12
    s_and_b32 s33, s13, 0xffff
    s_mov_b32 s34, 67108864
    s_mov_b32 s35, 0x20000
    buffer_load_dwordx4 v[8:11], v2, s[28:31], s36 offen offset:0 nt
    buffer_load_dwordx4 v[12:15], v2, s[28:31], s36 offen offset:64 nt
    buffer_load_dwordx4 v[16:19], v2, s[28:31], s36 offen offset:128 nt
    buffer_load_dwordx4 v[20:23], v2, s[28:31], s36 offen offset:192 nt
    s_barrier
    buffer_load_dwordx4 v[24:27], v2, s[28:31], s37 offen offset:0 nt
    buffer_load_dwordx4 v[28:31], v2, s[28:31], s37 offen offset:64 nt
    buffer_load_dwordx4 v[32:35], v2, s[28:31], s37 offen offset:128 nt
    buffer_load_dwordx4 v[36:39], v2, s[28:31], s37 offen offset:192 nt
    buffer_load_dwordx4 v[40:43], v2, s[28:31], s38 offen offset:0 nt
    buffer_load_dwordx4 v[44:47], v2, s[28:31], s38 offen offset:64 nt
    buffer_load_dwordx4 v[48:51], v2, s[28:31], s38 offen offset:128 nt
    buffer_load_dwordx4 v[52:55], v2, s[28:31], s38 offen offset:192 nt
    buffer_load_dwordx4 v[56:59], v2, s[28:31], s39 offen offset:0 nt
    buffer_load_dwordx4 v[60:63], v2, s[28:31], s39 offen offset:64 nt
    buffer_load_dwordx4 v[64:67], v2, s[28:31], s39 offen offset:128 nt
    buffer_load_dwordx4 v[68:71], v2, s[28:31], s39 offen offset:192 nt
    buffer_load_dwordx4 v[72:75], v3, s[32:35], s36 offen offset:0 nt
    buffer_load_dwordx4 v[76:79], v3, s[32:35], s36 offen offset:1024 nt
    buffer_load_dwordx4 v[80:83], v3, s[32:35], s36 offen offset:2048 nt
    buffer_load_dwordx4 v[84:87], v3, s[32:35], s36 offen offset:3072 nt
    buffer_load_dwordx4 v[88:91], v3, s[32:35], s37 offen offset:0 nt
    buffer_load_dwordx4 v[92:95], v3, s[32:35], s37 offen offset:1024 nt
    buffer_load_dwordx4 v[96:99], v3, s[32:35], s37 offen offset:2048 nt
    buffer_load_dwordx4 v[100:103], v3, s[32:35], s37 offen offset:3072 nt
    buffer_load_dwordx4 v[104:107], v3, s[32:35], s38 offen offset:0 nt
    buffer_load_dwordx4 v[108:111], v3, s[32:35], s38 offen offset:1024 nt
    buffer_load_dwordx4 v[112:115], v3, s[32:35], s38 offen offset:2048 nt
    buffer_load_dwordx4 v[116:119], v3, s[32:35], s38 offen offset:3072 nt
    buffer_load_dwordx4 v[120:123], v3, s[32:35], s39 offen offset:0 nt
    buffer_load_dwordx4 v[124:127], v3, s[32:35], s39 offen offset:1024 nt
    buffer_load_dwordx4 v[128:131], v3, s[32:35], s39 offen offset:2048 nt
    buffer_load_dwordx4 v[132:135], v3, s[32:35], s39 offen offset:3072 nt
    v_mov_b32 v5, 1
    v_mov_b32 v6, 16
    s_and_b64 exec, s[96:97], 1
    ds_add_u32 v6, v5
    s_mov_b64 exec, s[96:97]
    s_mov_b32 s48, s24
    s_and_b32 s49, s25, 0xffff
    s_mov_b32 s50, 285229056
    s_mov_b32 s51, 0x20000
    s_mov_b32 s64, 0xfffffc00
    v_and_b32 v7, 3, v1
    v_lshlrev_b32 v7, 8, v7
    v_lshl_add_u32 v7, v4, 4, v7
    v_mov_b32 v6, 8
    s_mov_b32 s60, 1048576
L_lw_1:
    ds_read_b32 v5, v6
    s_waitcnt lgkmcnt(0)
    v_readfirstlane_b32 s61, v5
    s_cbranch_execz L_lwd_2
    s_cmp_ge_u32 s61, 4
    s_cbranch_scc1 L_lwd_2
    s_sleep 2
    s_sub_u32 s60, s60, 1
    s_cmp_lg_u32 s60, 0
    s_cbranch_scc1 L_lw_1
L_lwd_2:
    s_setprio 1
    ds_read_b128 v[136:139], v7 offset:64
    ds_read_b128 v[140:143], v7 offset:128
    ds_read_b128 v[144:147], v7 offset:192
    ds_read_b128 v[148:151], v7 offset:256
    s_mov_b32 s40, 1040356334
    s_mov_b32 s41, 0x05040100
    s_mov_b32 s42, 0x07060302
    s_waitcnt lgkmcnt(0)
    s_waitcnt vmcnt(28)
    v_mfma_f32_16x16x32_bf16 v[152:155], v[8:11], v[136:139], 0
    v_mfma_f32_16x16x32_bf16 v[152:155], v[12:15], v[140:143], v[152:155]
    v_mfma_f32_16x16x32_bf16 v[152:155], v[16:19], v[144:147], v[152:155]
    v_mfma_f32_16x16x32_bf16 v[152:155], v[20:23], v[148:151], v[152:155]
    s_waitcnt vmcnt(24)
    v_mfma_f32_16x16x32_bf16 v[156:159], v[24:27], v[136:139], 0
    v_mfma_f32_16x16x32_bf16 v[156:159], v[28:31], v[140:143], v[156:159]
    v_mfma_f32_16x16x32_bf16 v[156:159], v[32:35], v[144:147], v[156:159]
    v_mfma_f32_16x16x32_bf16 v[156:159], v[36:39], v[148:151], v[156:159]
    s_waitcnt vmcnt(20)
    v_mfma_f32_16x16x32_bf16 v[160:163], v[40:43], v[136:139], 0
    v_mfma_f32_16x16x32_bf16 v[160:163], v[44:47], v[140:143], v[160:163]
    v_mfma_f32_16x16x32_bf16 v[160:163], v[48:51], v[144:147], v[160:163]
    v_mfma_f32_16x16x32_bf16 v[160:163], v[52:55], v[148:151], v[160:163]
    s_waitcnt vmcnt(16)
    v_mfma_f32_16x16x32_bf16 v[164:167], v[56:59], v[136:139], 0
    v_mfma_f32_16x16x32_bf16 v[164:167], v[60:63], v[140:143], v[164:167]
    v_mfma_f32_16x16x32_bf16 v[164:167], v[64:67], v[144:147], v[164:167]
    v_mfma_f32_16x16x32_bf16 v[164:167], v[68:71], v[148:151], v[164:167]
    v_and_b32 v5, 3, v1
    v_mul_u32_u24 v5, 528, v5
    v_lshl_add_u32 v5, v4, 7, v5
    s_mul_i32 s43, s7, 2112
    s_add_u32 s43, s43, 18432
    v_add_u32 v5, s43, v5
    s_nop 3
    v_max3_f32 v2, v152, v153, v154
    v_max3_f32 v2, v2, v155, v156
    v_max3_f32 v2, v2, v157, v158
    v_max3_f32 v2, v2, v159, v160
    v_max3_f32 v2, v2, v161, v162
    v_max3_f32 v2, v2, v163, v164
    v_max3_f32 v2, v2, v165, v166
    v_max_f32 v2, v2, v167
    v_mov_b32 v3, v2
    s_nop 1
    v_permlane32_swap_b32 v2, v3
    s_nop 1
    v_max_f32 v2, v2, v3
    v_mov_b32 v3, v2
    s_nop 1
    v_permlane16_swap_b32 v2, v3
    s_nop 1
    v_max_f32 v2, v2, v3
    v_mul_f32 v2, s40, v2
    v_fma_f32 v152, v152, s40, -v2
    v_fma_f32 v153, v153, s40, -v2
    v_fma_f32 v154, v154, s40, -v2
    v_fma_f32 v155, v155, s40, -v2
    v_fma_f32 v156, v156, s40, -v2
    v_fma_f32 v157, v157, s40, -v2
    v_fma_f32 v158, v158, s40, -v2
    v_fma_f32 v159, v159, s40, -v2
    v_fma_f32 v160, v160, s40, -v2
    v_fma_f32 v161, v161, s40, -v2
    v_fma_f32 v162, v162, s40, -v2
    v_fma_f32 v163, v163, s40, -v2
    v_fma_f32 v164, v164, s40, -v2
    v_fma_f32 v165, v165, s40, -v2
    v_fma_f32 v166, v166, s40, -v2
    v_fma_f32 v167, v167, s40, -v2
    v_exp_f32 v152, v152
    v_exp_f32 v153, v153
    v_exp_f32 v154, v154
    v_exp_f32 v155, v155
    v_exp_f32 v156, v156
    v_exp_f32 v157, v157
    v_exp_f32 v158, v158
    v_exp_f32 v159, v159
    v_exp_f32 v160, v160
    v_exp_f32 v161, v161
    v_exp_f32 v162, v162
    v_exp_f32 v163, v163
    v_exp_f32 v164, v164
    v_exp_f32 v165, v165
    v_exp_f32 v166, v166
    v_exp_f32 v167, v167
    s_nop 0
    v_cvt_pk_bf16_f32 v136, v152, v153
    v_cvt_pk_bf16_f32 v137, v154, v155
    v_cvt_pk_bf16_f32 v138, v156, v157
    v_cvt_pk_bf16_f32 v139, v158, v159
    v_cvt_pk_bf16_f32 v140, v160, v161
    v_cvt_pk_bf16_f32 v141, v162, v163
    v_cvt_pk_bf16_f32 v142, v164, v165
    v_cvt_pk_bf16_f32 v143, v166, v167
    v_add_f32 v3, v152, v153
    v_add_f32 v6, v154, v155
    v_add_f32 v3, v3, v156
    v_add_f32 v6, v6, v157
    v_add_f32 v3, v3, v158
    v_add_f32 v6, v6, v159
    v_add_f32 v3, v3, v160
    v_add_f32 v6, v6, v161
    v_add_f32 v3, v3, v162
    v_add_f32 v6, v6, v163
    v_add_f32 v3, v3, v164
    v_add_f32 v6, v6, v165
    v_add_f32 v3, v3, v166
    v_add_f32 v6, v6, v167
    v_add_f32 v3, v3, v6
    v_mov_b32 v6, v3
    s_nop 1
    v_permlane32_swap_b32 v3, v6
    s_nop 1
    v_add_f32 v3, v3, v6
    v_mov_b32 v6, v3
    s_nop 1
    v_permlane16_swap_b32 v3, v6
    s_nop 1
    v_add_f32 v3, v3, v6
    v_lshlrev_b32 v6, 5, v1
    s_lshl_b32 s43, s7, 2
    s_add_u32 s43, s43, 1088
    v_add_u32 v6, s43, v6
    s_mov_b64 exec, 15
    ds_write_b32 v6, v2
    ds_write_b32 v6, v3 offset:128
    s_mov_b64 exec, -1
    v_mov_b32 v7, 32
    ds_read_b128 v[144:147], v7
    s_and_b32 s43, s7, 3
    s_lshl_b32 s56, s93, 11
    s_lshl_b32 s55, s43, 9
    s_add_u32 s56, s56, s55
    s_add_u32 s56, s56, 1048576
    s_lshl_b32 s57, s93, 6
    s_lshl_b32 s55, s43, 4
    s_add_u32 s57, s57, s55
    s_add_u32 s57, s57, 1572864
    v_and_b32 v2, 31, v1
    v_lshlrev_b32 v2, 4, v2
    s_mul_i32 s54, s43, 528
    s_add_u32 s55, s54, 18432
    v_add_u32 v3, s55, v2
    s_add_u32 s55, s54, 35328
    v_add_u32 v150, s55, v2
    s_lshl_b32 s54, s43, 2
    s_add_u32 s54, s54, 48
    v_mov_b32 v151, s54
    s_lshl_b32 s54, s43, 5
    s_add_u32 s54, s54, 1088
    v_mov_b32 v6, s54
    v_mov_b32 v7, 12
    v_mov_b32 v148, 1
    s_waitcnt vmcnt(14)
    v_perm_b32 v40, v76, v72, s41
    v_perm_b32 v44, v76, v72, s42
    v_perm_b32 v48, v77, v73, s41
    v_perm_b32 v52, v77, v73, s42
    v_perm_b32 v56, v78, v74, s41
    v_perm_b32 v60, v78, v74, s42
    v_perm_b32 v64, v79, v75, s41
    v_perm_b32 v68, v79, v75, s42
    s_waitcnt vmcnt(12)
    v_perm_b32 v41, v84, v80, s41
    v_perm_b32 v45, v84, v80, s42
    v_perm_b32 v49, v85, v81, s41
    v_perm_b32 v53, v85, v81, s42
    v_perm_b32 v57, v86, v82, s41
    v_perm_b32 v61, v86, v82, s42
    v_perm_b32 v65, v87, v83, s41
    v_perm_b32 v69, v87, v83, s42
    s_waitcnt vmcnt(10)
    v_perm_b32 v42, v92, v88, s41
    v_perm_b32 v46, v92, v88, s42
    v_perm_b32 v50, v93, v89, s41
    v_perm_b32 v54, v93, v89, s42
    v_perm_b32 v58, v94, v90, s41
    v_perm_b32 v62, v94, v90, s42
    v_perm_b32 v66, v95, v91, s41
    v_perm_b32 v70, v95, v91, s42
    s_waitcnt vmcnt(8)
    v_perm_b32 v43, v100, v96, s41
    v_perm_b32 v47, v100, v96, s42
    v_perm_b32 v51, v101, v97, s41
    v_perm_b32 v55, v101, v97, s42
    v_perm_b32 v59, v102, v98, s41
    v_perm_b32 v63, v102, v98, s42
    v_perm_b32 v67, v103, v99, s41
    v_perm_b32 v71, v103, v99, s42
    s_nop 1
    v_mfma_f32_16x16x32_bf16 v[8:11], v[40:43], v[136:139], 0
    v_mfma_f32_16x16x32_bf16 v[12:15], v[44:47], v[136:139], 0
    v_mfma_f32_16x16x32_bf16 v[16:19], v[48:51], v[136:139], 0
    v_mfma_f32_16x16x32_bf16 v[20:23], v[52:55], v[136:139], 0
    v_mfma_f32_16x16x32_bf16 v[24:27], v[56:59], v[136:139], 0
    v_mfma_f32_16x16x32_bf16 v[28:31], v[60:63], v[136:139], 0
    v_mfma_f32_16x16x32_bf16 v[32:35], v[64:67], v[136:139], 0
    v_mfma_f32_16x16x32_bf16 v[36:39], v[68:71], v[136:139], 0
    s_waitcnt vmcnt(6)
    v_perm_b32 v40, v108, v104, s41
    v_perm_b32 v44, v108, v104, s42
    v_perm_b32 v48, v109, v105, s41
    v_perm_b32 v52, v109, v105, s42
    v_perm_b32 v56, v110, v106, s41
    v_perm_b32 v60, v110, v106, s42
    v_perm_b32 v64, v111, v107, s41
    v_perm_b32 v68, v111, v107, s42
    s_waitcnt vmcnt(4)
    v_perm_b32 v41, v116, v112, s41
    v_perm_b32 v45, v116, v112, s42
    v_perm_b32 v49, v117, v113, s41
    v_perm_b32 v53, v117, v113, s42
    v_perm_b32 v57, v118, v114, s41
    v_perm_b32 v61, v118, v114, s42
    v_perm_b32 v65, v119, v115, s41
    v_perm_b32 v69, v119, v115, s42
    s_waitcnt vmcnt(2)
    v_perm_b32 v42, v124, v120, s41
    v_perm_b32 v46, v124, v120, s42
    v_perm_b32 v50, v125, v121, s41
    v_perm_b32 v54, v125, v121, s42
    v_perm_b32 v58, v126, v122, s41
    v_perm_b32 v62, v126, v122, s42
    v_perm_b32 v66, v127, v123, s41
    v_perm_b32 v70, v127, v123, s42
    s_waitcnt vmcnt(0)
    v_perm_b32 v43, v132, v128, s41
    v_perm_b32 v47, v132, v128, s42
    v_perm_b32 v51, v133, v129, s41
    v_perm_b32 v55, v133, v129, s42
    v_perm_b32 v59, v134, v130, s41
    v_perm_b32 v63, v134, v130, s42
    v_perm_b32 v67, v135, v131, s41
    v_perm_b32 v71, v135, v131, s42
    s_nop 1
    v_mfma_f32_16x16x32_bf16 v[8:11], v[40:43], v[140:143], v[8:11]
    v_mfma_f32_16x16x32_bf16 v[12:15], v[44:47], v[140:143], v[12:15]
    v_mfma_f32_16x16x32_bf16 v[16:19], v[48:51], v[140:143], v[16:19]
    v_mfma_f32_16x16x32_bf16 v[20:23], v[52:55], v[140:143], v[20:23]
    v_mfma_f32_16x16x32_bf16 v[24:27], v[56:59], v[140:143], v[24:27]
    v_mfma_f32_16x16x32_bf16 v[28:31], v[60:63], v[140:143], v[28:31]
    v_mfma_f32_16x16x32_bf16 v[32:35], v[64:67], v[140:143], v[32:35]
    v_mfma_f32_16x16x32_bf16 v[36:39], v[68:71], v[140:143], v[36:39]
    s_mov_b32 exec_lo, 0x000f000f
    s_mov_b32 exec_hi, 0x000f000f
    s_nop 0
    ds_write_b128 v5, v[8:11] offset:0
    ds_write_b128 v5, v[12:15] offset:16
    ds_write_b128 v5, v[16:19] offset:32
    ds_write_b128 v5, v[20:23] offset:48
    ds_write_b128 v5, v[24:27] offset:64
    ds_write_b128 v5, v[28:31] offset:80
    ds_write_b128 v5, v[32:35] offset:96
    s_nop 0
    ds_write_b128 v5, v[36:39] offset:112
    s_mov_b64 exec, 1
    s_waitcnt lgkmcnt(0)
    ds_add_u32 v7, v148
    s_setprio 0
    s_cmp_lt_u32 s7, 4
    s_cselect_b64 s[96:97], 0, -1
    s_mov_b64 exec, s[96:97]
    s_mov_b32 s60, 1048576
L_lw_3:
    ds_read_b32 v149, v7
    s_waitcnt lgkmcnt(0)
    v_readfirstlane_b32 s61, v149
    s_cbranch_execz L_lwd_4
    s_cmp_ge_u32 s61, 8
    s_cbranch_scc1 L_lwd_4
    s_sub_u32 s60, s60, 1
    s_cmp_lg_u32 s60, 0
    s_cbranch_scc1 L_lw_3
L_lwd_4:
    s_setprio 1
    ds_read_b128 v[72:75], v6
    ds_read_b128 v[76:79], v6 offset:16
    ds_read_b128 v[80:83], v6 offset:128
    ds_read_b128 v[84:87], v6 offset:144
    ds_read_b128 v[8:11], v3 offset:0
    ds_read_b128 v[12:15], v3 offset:2112
    ds_read_b128 v[16:19], v3 offset:4224
    ds_read_b128 v[20:23], v3 offset:6336
    ds_read_b128 v[24:27], v3 offset:8448
    ds_read_b128 v[28:31], v3 offset:10560
    ds_read_b128 v[32:35], v3 offset:12672
    ds_read_b128 v[36:39], v3 offset:14784
    s_waitcnt lgkmcnt(10)
    v_max3_f32 v90, v72, v73, v74
    v_max3_f32 v90, v90, v75, v76
    v_max3_f32 v90, v90, v77, v78
    v_max_f32 v90, v90, v79
    v_sub_f32 v72, v72, v90
    v_sub_f32 v73, v73, v90
    v_sub_f32 v74, v74, v90
    v_sub_f32 v75, v75, v90
    v_sub_f32 v76, v76, v90
    v_sub_f32 v77, v77, v90
    v_sub_f32 v78, v78, v90
    v_sub_f32 v79, v79, v90
    v_exp_f32 v72, v72
    v_exp_f32 v73, v73
    v_exp_f32 v74, v74
    v_exp_f32 v75, v75
    v_exp_f32 v76, v76
    v_exp_f32 v77, v77
    v_exp_f32 v78, v78
    v_exp_f32 v79, v79
    s_waitcnt lgkmcnt(8)
    v_mul_f32 v91, v72, v80
    v_fmac_f32 v91, v73, v81
    v_fmac_f32 v91, v74, v82
    v_fmac_f32 v91, v75, v83
    v_fmac_f32 v91, v76, v84
    v_fmac_f32 v91, v77, v85
    v_fmac_f32 v91, v78, v86
    v_fmac_f32 v91, v79, v87
    v_rcp_f32 v92, v91
    v_log_f32 v93, v91
    s_waitcnt lgkmcnt(0)
    v_mul_f32 v96, v72, v8
    v_mul_f32 v97, v72, v9
    v_mul_f32 v98, v72, v10
    v_mul_f32 v99, v72, v11
    v_fmac_f32 v96, v73, v12
    v_fmac_f32 v97, v73, v13
    v_fmac_f32 v98, v73, v14
    v_fmac_f32 v99, v73, v15
    v_fmac_f32 v96, v74, v16
    v_fmac_f32 v97, v74, v17
    v_fmac_f32 v98, v74, v18
    v_fmac_f32 v99, v74, v19
    v_fmac_f32 v96, v75, v20
    v_fmac_f32 v97, v75, v21
    v_fmac_f32 v98, v75, v22
    v_fmac_f32 v99, v75, v23
    v_fmac_f32 v96, v76, v24
    v_fmac_f32 v97, v76, v25
    v_fmac_f32 v98, v76, v26
    v_fmac_f32 v99, v76, v27
    v_fmac_f32 v96, v77, v28
    v_fmac_f32 v97, v77, v29
    v_fmac_f32 v98, v77, v30
    v_fmac_f32 v99, v77, v31
    v_fmac_f32 v96, v78, v32
    v_fmac_f32 v97, v78, v33
    v_fmac_f32 v98, v78, v34
    v_fmac_f32 v99, v78, v35
    v_fmac_f32 v96, v79, v36
    v_fmac_f32 v97, v79, v37
    v_fmac_f32 v98, v79, v38
    v_fmac_f32 v99, v79, v39
    v_add_f32 v93, v93, v90
    v_mul_f32 v96, v92, v96
    v_mul_f32 v97, v92, v97
    v_mul_f32 v98, v92, v98
    v_mul_f32 v99, v92, v99
    v_bfi_b32 v96, s64, v96, v144
    v_bfi_b32 v97, s64, v97, v145
    v_bfi_b32 v98, s64, v98, v146
    v_bfi_b32 v99, s64, v99, v147
    s_mov_b32 exec_hi, 0
    s_cbranch_execz L_lo_5
    buffer_store_dwordx4 v[96:99], v2, s[48:51], s56 offen
L_lo_5:
    v_and_b32 v94, s64, v93
    v_sub_f32 v94, v93, v94
    v_bfi_b32 v100, s64, v93, v144
    v_bfi_b32 v101, s64, v94, v145
    v_bfi_b32 v102, s64, v93, v146
    v_bfi_b32 v103, s64, v93, v147
    ds_write_b128 v150, v[96:99]
    s_and_b64 exec, s[96:97], 1
    s_cbranch_execz L_lo_6
    buffer_store_dwordx4 v[100:103], v2, s[48:51], s57 offen
L_lo_6:
    ds_write_b128 v150, v[100:103] offset:512
    s_waitcnt lgkmcnt(0)
    ds_write_b32 v151, v148
L_aend:
    s_endpgm
L_helper:
    s_mov_b32 s40, s22
    s_and_b32 s41, s23, 0xffff
    s_mov_b32 s42, 256
    s_mov_b32 s43, 0x20000
    s_mov_b32 s65, 3145728
    s_mov_b32 s64, 0xfffffc00
    v_lshlrev_b32 v6, 4, v1
    s_mov_b32 s58, 0x05040100
    s_mov_b32 s59, 0x07060302
    s_mov_b32 s98, 0
    s_mov_b32 s99, 0
    s_cmp_lg_u32 s6, 0
    s_cbranch_scc1 L_noepoch
    s_load_dwordx2 s[62:63], s[24:25], s65
    s_waitcnt lgkmcnt(0)
    s_add_u32 s62, s62, 1
    s_addc_u32 s63, s63, 0
    s_and_b32 s54, s62, 0x3ff
    v_mov_b32 v108, s54
    s_lshr_b32 s54, s62, 10
    s_add_u32 s54, s54, s62
    s_and_b32 s54, s54, 0x3ff
    v_mov_b32 v109, s54
    s_lshr_b32 s54, s62, 20
    s_add_u32 s54, s54, s62
    s_and_b32 s54, s54, 0x3ff
    v_mov_b32 v110, s54
    s_lshr_b64 s[54:55], s[62:63], 30
    s_add_u32 s54, s54, s62
    s_and_b32 s54, s54, 0x3ff
    v_mov_b32 v111, s54
    v_mov_b32 v113, 32
    s_mov_b64 exec, 1
    ds_write_b128 v113, v[108:111]
    s_mov_b64 exec, -1
L_noepoch:
    s_waitcnt vmcnt(7)
    v_perm_b32 v44, v12, v8, s58
    v_perm_b32 v48, v12, v8, s59
    v_perm_b32 v52, v13, v9, s58
    v_perm_b32 v56, v13, v9, s59
    v_perm_b32 v60, v14, v10, s58
    v_perm_b32 v64, v14, v10, s59
    v_perm_b32 v68, v15, v11, s58
    v_perm_b32 v72, v15, v11, s59
    s_waitcnt vmcnt(5)
    v_perm_b32 v45, v20, v16, s58
    v_perm_b32 v49, v20, v16, s59
    v_perm_b32 v53, v21, v17, s58
    v_perm_b32 v57, v21, v17, s59
    v_perm_b32 v61, v22, v18, s58
    v_perm_b32 v65, v22, v18, s59
    v_perm_b32 v69, v23, v19, s58
    v_perm_b32 v73, v23, v19, s59
    s_waitcnt vmcnt(3)
    v_perm_b32 v46, v28, v24, s58
    v_perm_b32 v50, v28, v24, s59
    v_perm_b32 v54, v29, v25, s58
    v_perm_b32 v58, v29, v25, s59
    v_perm_b32 v62, v30, v26, s58
    v_perm_b32 v66, v30, v26, s59
    v_perm_b32 v70, v31, v27, s58
    v_perm_b32 v74, v31, v27, s59
    s_waitcnt vmcnt(1)
    v_perm_b32 v47, v36, v32, s58
    v_perm_b32 v51, v36, v32, s59
    v_perm_b32 v55, v37, v33, s58
    v_perm_b32 v59, v37, v33, s59
    v_perm_b32 v63, v38, v34, s58
    v_perm_b32 v67, v38, v34, s59
    v_perm_b32 v71, v39, v35, s58
    v_perm_b32 v75, v39, v35, s59
    v_mul_u32_u24 v7, 528, v5
    v_lshl_add_u32 v7, v4, 7, v7
    s_mul_i32 s54, s6, 4224
    s_add_u32 s54, s54, 1536
    v_add_u32 v7, s54, v7
    s_waitcnt vmcnt(0)
    v_mfma_f32_16x16x32_bf16 v[76:79], v[44:47], v[40:43], 0
    v_mfma_f32_16x16x32_bf16 v[80:83], v[48:51], v[40:43], 0
    v_mfma_f32_16x16x32_bf16 v[84:87], v[52:55], v[40:43], 0
    v_mfma_f32_16x16x32_bf16 v[88:91], v[56:59], v[40:43], 0
    v_mfma_f32_16x16x32_bf16 v[92:95], v[60:63], v[40:43], 0
    v_mfma_f32_16x16x32_bf16 v[96:99], v[64:67], v[40:43], 0
    v_mfma_f32_16x16x32_bf16 v[100:103], v[68:71], v[40:43], 0
    v_mfma_f32_16x16x32_bf16 v[104:107], v[72:75], v[40:43], 0
    v_lshrrev_b32 v2, 5, v1
    s_lshl_b32 s54, s6, 1
    v_add_u32 v2, s54, v2
    v_and_b32 v3, 31, v1
    v_mul_u32_u24 v112, 528, v2
    v_lshl_add_u32 v112, v3, 4, v112
    v_add_u32 v112, 1536, v112
    v_mov_b32 v132, 0
    v_mov_b32 v133, 1
    s_and_b32 exec_lo, s96, 0xff00ff
    s_and_b32 exec_hi, s97, 0xff00ff
    ds_write_b128 v7, v[76:79] offset:0
    ds_write_b128 v7, v[80:83] offset:16
    ds_write_b128 v7, v[84:87] offset:32
    ds_write_b128 v7, v[88:91] offset:48
    ds_write_b128 v7, v[92:95] offset:64
    ds_write_b128 v7, v[96:99] offset:80
    ds_write_b128 v7, v[100:103] offset:96
    ds_write_b128 v7, v[104:107] offset:112
    s_and_b64 exec, s[96:97], 1
    s_waitcnt lgkmcnt(0)
    ds_add_u32 v132, v133
    s_mov_b64 exec, s[96:97]
    s_mov_b32 s60, 1048576
L_lw_7:
    ds_read_b32 v133, v132
    s_waitcnt lgkmcnt(0)
    v_readfirstlane_b32 s61, v133
    s_cbranch_execz L_lwd_8
    s_cmp_ge_u32 s61, 4
    s_cbranch_scc1 L_lwd_8
    s_sub_u32 s60, s60, 1
    s_cmp_lg_u32 s60, 0
    s_cbranch_scc1 L_lw_7
L_lwd_8:
    v_mov_b32 v132, 32
    ds_read_b128 v[108:111], v132
    ds_read_b128 v[116:119], v112 offset:0
    ds_read_b128 v[120:123], v112 offset:4224
    ds_read_b128 v[124:127], v112 offset:8448
    ds_read_b128 v[128:131], v112 offset:12672
    s_waitcnt lgkmcnt(0)
    v_add_f32 v116, v116, v120
    v_add_f32 v124, v124, v128
    v_add_f32 v117, v117, v121
    v_add_f32 v125, v125, v129
    v_add_f32 v118, v118, v122
    v_add_f32 v126, v126, v130
    v_add_f32 v119, v119, v123
    v_add_f32 v127, v127, v131
    v_add_f32 v116, v116, v124
    v_add_f32 v117, v117, v125
    v_add_f32 v118, v118, v126
    v_add_f32 v119, v119, v127
    v_bfi_b32 v116, s64, v116, v108
    v_bfi_b32 v117, s64, v117, v109
    v_bfi_b32 v118, s64, v118, v110
    v_bfi_b32 v119, s64, v119, v111
    v_lshlrev_b32 v0, 16, v2
    v_lshl_add_u32 v0, v3, 4, v0
    s_lshl_b32 s95, s3, 19
    s_lshl_b32 s55, s27, 11
    s_add_u32 s95, s95, s55
    s_lshl_b32 s55, s52, 9
    s_add_u32 s95, s95, s55
    buffer_store_dwordx4 v[116:119], v0, s[48:51], s95 offen
    s_lshr_b32 s54, s94, 1
    s_lshl_b32 s54, s54, 13
    s_lshl_b32 s55, s3, 19
    s_add_u32 s54, s54, s55
    s_lshl_b32 s55, s6, 11
    s_add_u32 s54, s54, s55
    v_lshrrev_b32 v113, 5, v1
    v_lshlrev_b32 v113, 10, v113
    v_lshl_add_u32 v113, v3, 4, v113
    v_lshrrev_b32 v114, 3, v3
    v_lshlrev_b32 v114, 6, v114
    v_and_b32 v115, 7, v3
    v_lshl_add_u32 v114, v115, 1, v114
    s_lshl_b32 s55, s6, 8
    s_add_u32 s55, s55, 64
    v_add_u32 v114, s55, v114
    s_mov_b32 s60, 1048576
L_pa_q:
    s_cbranch_execz L_lo_9
    buffer_load_dwordx4 v[120:123], v113, s[48:51], s54 offen sc1
    buffer_load_dwordx4 v[124:127], v113, s[48:51], s54 offen offset:512 sc1
    s_waitcnt vmcnt(0)
L_lo_9:
    v_xor_b32 v136, v120, v108
    v_xor_b32 v137, v121, v109
    v_xor_b32 v138, v122, v110
    v_xor_b32 v139, v123, v111
    v_xor_b32 v140, v124, v108
    v_xor_b32 v141, v125, v109
    v_xor_b32 v142, v126, v110
    v_xor_b32 v143, v127, v111
    v_or3_b32 v156, v136, v137, v138
    v_or3_b32 v157, v139, v140, v141
    v_or3_b32 v156, v156, v157, v142
    v_or_b32 v156, v156, v143
    v_and_b32 v156, 0x3ff, v156
    v_cmp_ne_u32 vcc, 0, v156
    s_cbranch_vccz L_pok_q
    s_mov_b64 exec, vcc
    s_sleep 4
    s_cmp_gt_u32 s60, 1048320
    s_cbranch_scc1 L_tg_qa
    s_xor_b32 s54, s54, 8388608
    s_cbranch_execz L_pq_qa
    s_cmp_lg_u32 s98, 0
    s_cbranch_scc1 L_pq_qa
    s_mov_b64 s[30:31], exec
    s_mov_b64 exec, -1
    s_add_u32 s95, s95, 8388608
    buffer_store_dwordx4 v[116:119], v0, s[48:51], s95 offen sc1
    s_mov_b32 s98, 1
    s_mov_b64 exec, s[30:31]
L_pq_qa:
L_tg_qa:
    s_sub_u32 s60, s60, 1
    s_cmp_lg_u32 s60, 0
    s_cbranch_scc1 L_pa_q
L_pok_q:
    s_mov_b64 exec, s[96:97]
    v_add_f32 v120, v136, v140
    v_add_f32 v121, v137, v141
    v_add_f32 v122, v138, v142
    v_add_f32 v123, v139, v143
    v_mov_b32 v124, v120
    v_mov_b32 v125, v121
    v_mov_b32 v126, v122
    v_mov_b32 v127, v123
    s_nop 1
    v_permlane32_swap_b32 v120, v124
    v_permlane32_swap_b32 v121, v125
    v_permlane32_swap_b32 v122, v126
    v_permlane32_swap_b32 v123, v127
    s_nop 1
    v_add_f32 v120, v120, v124
    v_add_f32 v121, v121, v125
    v_add_f32 v122, v122, v126
    v_add_f32 v123, v123, v127
    v_cvt_pk_bf16_f32 v120, v120, v121
    v_cvt_pk_bf16_f32 v122, v122, v123
    s_mov_b32 exec_hi, 0
    ds_write_b16 v114, v120
    ds_write_b16_d16_hi v114, v120 offset:16
    ds_write_b16 v114, v122 offset:32
    ds_write_b16_d16_hi v114, v122 offset:48
    s_waitcnt lgkmcnt(0)
    s_mov_b64 exec, -1
    v_mov_b32 v113, 1
    v_mov_b32 v114, 8
    s_and_b64 exec, s[96:97], 1
    ds_add_u32 v114, v113
    s_mov_b64 exec, s[96:97]
    v_lshlrev_b32 v115, 11, v4
    v_lshl_add_u32 v115, v5, 4, v115
    s_lshl_b32 s56, s27, 7
    s_lshl_b32 s55, s6, 5
    s_add_u32 s56, s56, s55
    s_lshl_b32 s56, s56, 10
    s_lshl_b32 s55, s52, 8
    s_add_u32 s56, s56, s55
    v_and_b32 v113, 7, v1
    v_lshlrev_b32 v113, 4, v113
    v_bfe_u32 v114, v1, 3, 1
    v_add_u32 v113, v113, v114
    s_lshr_b32 s54, s27, 2
    s_lshl_b32 s54, s54, 1
    s_lshl_b32 s55, s3, 7
    s_add_u32 s54, s54, s55
    v_add_u32 v113, s54, v113
    v_lshlrev_b32 v114, 6, v113
    v_lshlrev_b32 v113, 11, v113
    v_lshl_add_u32 v113, v4, 5, v113
    s_and_b32 s55, s27, 3
    s_lshl_b32 s54, s55, 9
    s_lshl_b32 s53, s6, 7
    s_add_u32 s54, s54, s53
    s_add_u32 s54, s54, 1048576
    s_lshl_b32 s55, s55, 4
    s_add_u32 s55, s55, 1572864
    v_lshlrev_b32 v134, 2, v2
    v_lshrrev_b32 v135, 3, v3
    v_add_u32 v134, v134, v135
    v_lshlrev_b32 v134, 12, v134
    v_and_b32 v135, 7, v3
    v_lshl_add_u32 v134, v135, 4, v134
    s_lshl_b32 s53, s3, 19
    s_lshl_b32 s57, s52, 17
    s_add_u32 s53, s53, s57
    s_lshl_b32 s57, s27, 7
    s_add_u32 s53, s53, s57
    s_add_u32 s53, s53, 2097152
    s_xor_b32 s100, s92, 128
    s_lshl_b32 s100, s100, 12
    s_add_u32 s100, s100, 2097152
    s_bfe_u32 s101, s26, 0x30002
    s_lshl_b32 s101, s101, 11
    s_xor_b32 s57, s3, 1
    s_lshl_b32 s57, s57, 10
    s_add_u32 s101, s101, s57
    s_lshr_b32 s57, s26, 5
    s_lshl_b32 s57, s57, 8
    s_add_u32 s101, s101, s57
    s_and_b32 s57, s26, 3
    s_lshl_b32 s57, s57, 6
    s_add_u32 s101, s101, s57
    v_lshlrev_b32 v135, 1, v1
    v_bfe_u32 v136, v1, 3, 2
    v_cmp_eq_u32 s[8:9], 1, v136
    v_cmp_eq_u32 s[10:11], 2, v136
    v_cmp_eq_u32 s[12:13], 3, v136
    s_mov_b64 exec, 1
    buffer_load_dword v160, v134, s[48:51], s53 offen
    buffer_load_dword v161, v6, s[48:51], s100 offen
    buffer_load_ushort v162, v135, s[44:47], s101 offen
    buffer_load_dword v163, v115, s[36:39], s56 offen
    s_mov_b64 exec, -1
    s_cmp_lg_u32 s6, 3
    s_cbranch_scc1 L_noarr
    v_mov_b32 v132, 0
    v_mov_b32 v133, 1
    s_mov_b64 exec, 1
    buffer_atomic_add v133, v132, s[40:43], 0 offen
    s_mov_b64 exec, -1
    s_branch L_tail
L_noarr:
    s_mov_b64 s[96:97], 0
    s_mov_b64 exec, 0
L_tail:
    v_mov_b32 v132, 16
    s_mov_b32 s60, 1048576
L_lw_10:
    ds_read_b32 v133, v132
    s_waitcnt lgkmcnt(0)
    v_readfirstlane_b32 s61, v133
    s_cbranch_execz L_lwd_11
    s_cmp_ge_u32 s61, 8
    s_cbranch_scc1 L_lwd_11
    s_sleep 2
    s_sub_u32 s60, s60, 1
    s_cmp_lg_u32 s60, 0
    s_cbranch_scc1 L_lw_10
L_lwd_11:
    s_cbranch_execz L_pq_c4
    s_cmp_lg_u32 s98, 0
    s_cbranch_scc1 L_pq_c4
    s_mov_b64 s[30:31], exec
    s_mov_b64 exec, -1
    s_add_u32 s95, s95, 8388608
    buffer_store_dwordx4 v[116:119], v0, s[48:51], s95 offen sc1
    s_mov_b32 s98, 1
    s_mov_b64 exec, s[30:31]
L_pq_c4:
    s_cbranch_execz L_lo_12
    s_add_u32 s57, s56, 0
    buffer_load_dwordx4 v[8:11], v115, s[36:39], s57 offen offset:0 nt
    s_add_u32 s57, s56, 8192
    buffer_load_dwordx4 v[12:15], v115, s[36:39], s57 offen offset:0 nt
    s_add_u32 s57, s56, 16384
    buffer_load_dwordx4 v[16:19], v115, s[36:39], s57 offen offset:0 nt
    s_add_u32 s57, s56, 24576
    buffer_load_dwordx4 v[20:23], v115, s[36:39], s57 offen offset:0 nt
    s_add_u32 s57, s56, 0
    buffer_load_dwordx4 v[24:27], v115, s[36:39], s57 offen offset:1024 nt
    s_add_u32 s57, s56, 8192
    buffer_load_dwordx4 v[28:31], v115, s[36:39], s57 offen offset:1024 nt
    s_add_u32 s57, s56, 16384
    buffer_load_dwordx4 v[32:35], v115, s[36:39], s57 offen offset:1024 nt
    s_add_u32 s57, s56, 24576
    buffer_load_dwordx4 v[36:39], v115, s[36:39], s57 offen offset:1024 nt
L_lo_12:
    s_waitcnt vmcnt(6)
    v_perm_b32 v44, v12, v8, s58
    v_perm_b32 v48, v12, v8, s59
    v_perm_b32 v52, v13, v9, s58
    v_perm_b32 v56, v13, v9, s59
    v_perm_b32 v60, v14, v10, s58
    v_perm_b32 v64, v14, v10, s59
    v_perm_b32 v68, v15, v11, s58
    v_perm_b32 v72, v15, v11, s59
    s_waitcnt vmcnt(4)
    v_perm_b32 v45, v20, v16, s58
    v_perm_b32 v49, v20, v16, s59
    v_perm_b32 v53, v21, v17, s58
    v_perm_b32 v57, v21, v17, s59
    v_perm_b32 v61, v22, v18, s58
    v_perm_b32 v65, v22, v18, s59
    v_perm_b32 v69, v23, v19, s58
    v_perm_b32 v73, v23, v19, s59
    s_waitcnt vmcnt(2)
    v_perm_b32 v46, v28, v24, s58
    v_perm_b32 v50, v28, v24, s59
    v_perm_b32 v54, v29, v25, s58
    v_perm_b32 v58, v29, v25, s59
    v_perm_b32 v62, v30, v26, s58
    v_perm_b32 v66, v30, v26, s59
    v_perm_b32 v70, v31, v27, s58
    v_perm_b32 v74, v31, v27, s59
    s_waitcnt vmcnt(0)
    v_perm_b32 v47, v36, v32, s58
    v_perm_b32 v51, v36, v32, s59
    v_perm_b32 v55, v37, v33, s58
    v_perm_b32 v59, v37, v33, s59
    v_perm_b32 v63, v38, v34, s58
    v_perm_b32 v67, v38, v34, s59
    v_perm_b32 v71, v39, v35, s58
    v_perm_b32 v75, v39, v35, s59
    s_mov_b32 s60, 1048576
L_pa_o:
    s_cbranch_execz L_lo_13
    buffer_load_dwordx4 v[144:147], v113, s[48:51], s54 offen sc1
    buffer_load_dwordx4 v[148:151], v113, s[48:51], s54 offen offset:16 sc1
    buffer_load_dwordx4 v[152:155], v114, s[48:51], s55 offen sc1
    s_waitcnt vmcnt(0)
L_lo_13:
    v_xor_b32 v116, v144, v108
    v_xor_b32 v117, v145, v109
    v_xor_b32 v118, v146, v110
    v_xor_b32 v119, v147, v111
    v_xor_b32 v120, v148, v108
    v_xor_b32 v121, v149, v109
    v_xor_b32 v122, v150, v110
    v_xor_b32 v123, v151, v111
    v_xor_b32 v124, v152, v108
    v_xor_b32 v125, v153, v109
    v_xor_b32 v126, v154, v110
    v_xor_b32 v127, v155, v111
    v_or3_b32 v156, v116, v117, v118
    v_or3_b32 v157, v119, v120, v121
    v_or3_b32 v158, v122, v123, v124
    v_or3_b32 v159, v125, v126, v127
    v_or3_b32 v156, v156, v157, v158
    v_or_b32 v159, v156, v159
    v_and_b32 v159, 0x3ff, v159
    v_cmp_ne_u32 vcc, 0, v159
    s_cbranch_execz L_pbs_o
    s_cbranch_vccz L_pok_o
    s_mov_b64 exec, vcc
    s_bcnt1_i32_b64 s61, vcc
    s_cmp_le_u32 s61, 16
    s_cbranch_scc1 L_pbs_o
    s_sleep 1
    s_cmp_gt_u32 s60, 1048320
    s_cbranch_scc1 L_tg_oa
    s_xor_b32 s54, s54, 8388608
    s_xor_b32 s55, s55, 8388608
    s_cbranch_execz L_po_oa
    s_cmp_lg_u32 s99, 0
    s_cbranch_scc1 L_po_oa
    s_mov_b64 s[30:31], exec
    s_mov_b64 exec, -1
    s_lshl_b32 s32, s6, 2
    s_add_u32 s32, s32, 48
    v_mov_b32 v137, s32
    ds_read_b32 v138, v137
    s_waitcnt lgkmcnt(0)
    v_readfirstlane_b32 s32, v138
    s_cmp_eq_u32 s32, 0
    s_cbranch_scc1 L_por_oa
    s_mul_i32 s32, s6, 528
    s_add_u32 s32, s32, 35328
    v_lshlrev_b32 v137, 4, v3
    v_add_u32 v138, s32, v137
    v_mov_b32 v139, s32
    ds_read_b128 v[140:143], v138
    ds_read_b128 v[164:167], v139 offset:512
    s_lshl_b32 s32, s93, 11
    s_lshl_b32 s33, s6, 9
    s_add_u32 s32, s32, s33
    s_add_u32 s32, s32, 9437184
    s_lshl_b32 s34, s93, 6
    s_lshl_b32 s33, s6, 4
    s_add_u32 s34, s34, s33
    s_add_u32 s34, s34, 9961472
    s_waitcnt lgkmcnt(0)
    s_mov_b32 exec_hi, 0
    buffer_store_dwordx4 v[140:143], v137, s[48:51], s32 offen sc1
    s_mov_b64 exec, 1
    buffer_store_dwordx4 v[164:167], v137, s[48:51], s34 offen sc1
    s_mov_b32 s99, 1
L_por_oa:
    s_mov_b64 exec, s[30:31]
L_po_oa:
L_tg_oa:
    s_sub_u32 s60, s60, 1
    s_cmp_lg_u32 s60, 0
    s_cbranch_scc1 L_pa_o
    s_branch L_pok_o
L_pbs_o:
    s_cbranch_execz L_lo_14
    buffer_load_dwordx4 v[144:147], v113, s[48:51], s54 offen sc1
    buffer_load_dwordx4 v[148:151], v113, s[48:51], s54 offen offset:16 sc1
    buffer_load_dwordx4 v[152:155], v114, s[48:51], s55 offen sc1
    buffer_load_dwordx4 v[8:11], v113, s[48:51], s54 offen sc1
    buffer_load_dwordx4 v[12:15], v113, s[48:51], s54 offen offset:16 sc1
    buffer_load_dwordx4 v[16:19], v114, s[48:51], s55 offen sc1
    buffer_load_dwordx4 v[20:23], v113, s[48:51], s54 offen sc1
    buffer_load_dwordx4 v[24:27], v113, s[48:51], s54 offen offset:16 sc1
    buffer_load_dwordx4 v[28:31], v114, s[48:51], s55 offen sc1
L_lo_14:
L_pb_o:
    s_cbranch_execz L_lo_15
    s_waitcnt vmcnt(6)
L_lo_15:
    v_xor_b32 v116, v144, v108
    v_xor_b32 v117, v145, v109
    v_xor_b32 v118, v146, v110
    v_xor_b32 v119, v147, v111
    v_xor_b32 v120, v148, v108
    v_xor_b32 v121, v149, v109
    v_xor_b32 v122, v150, v110
    v_xor_b32 v123, v151, v111
    v_xor_b32 v124, v152, v108
    v_xor_b32 v125, v153, v109
    v_xor_b32 v126, v154, v110
    v_xor_b32 v127, v155, v111
    v_or3_b32 v156, v116, v117, v118
    v_or3_b32 v157, v119, v120, v121
    v_or3_b32 v158, v122, v123, v124
    v_or3_b32 v159, v125, v126, v127
    v_or3_b32 v156, v156, v157, v158
    v_or_b32 v159, v156, v159
    v_and_b32 v159, 0x3ff, v159
    v_cmp_ne_u32 vcc, 0, v159
    s_cbranch_execz L_pbd_o0
    s_cbranch_vccz L_pok_o
    s_mov_b64 exec, vcc
    s_cmp_gt_u32 s60, 1048320
    s_cbranch_scc1 L_tg_ob
    s_xor_b32 s54, s54, 8388608
    s_xor_b32 s55, s55, 8388608
    s_cbranch_execz L_po_ob
    s_cmp_lg_u32 s99, 0
    s_cbranch_scc1 L_po_ob
    s_mov_b64 s[30:31], exec
    s_mov_b64 exec, -1
    s_lshl_b32 s32, s6, 2
    s_add_u32 s32, s32, 48
    v_mov_b32 v137, s32
    ds_read_b32 v138, v137
    s_waitcnt lgkmcnt(0)
    v_readfirstlane_b32 s32, v138
    s_cmp_eq_u32 s32, 0
    s_cbranch_scc1 L_por_ob
    s_mul_i32 s32, s6, 528
    s_add_u32 s32, s32, 35328
    v_lshlrev_b32 v137, 4, v3
    v_add_u32 v138, s32, v137
    v_mov_b32 v139, s32
    ds_read_b128 v[140:143], v138
    ds_read_b128 v[164:167], v139 offset:512
    s_lshl_b32 s32, s93, 11
    s_lshl_b32 s33, s6, 9
    s_add_u32 s32, s32, s33
    s_add_u32 s32, s32, 9437184
    s_lshl_b32 s34, s93, 6
    s_lshl_b32 s33, s6, 4
    s_add_u32 s34, s34, s33
    s_add_u32 s34, s34, 9961472
    s_waitcnt lgkmcnt(0)
    s_mov_b32 exec_hi, 0
    buffer_store_dwordx4 v[140:143], v137, s[48:51], s32 offen sc1
    s_mov_b64 exec, 1
    buffer_store_dwordx4 v[164:167], v137, s[48:51], s34 offen sc1
    s_mov_b32 s99, 1
L_por_ob:
    s_mov_b64 exec, s[30:31]
L_po_ob:
L_tg_ob:
    buffer_load_dwordx4 v[144:147], v113, s[48:51], s54 offen sc1
    buffer_load_dwordx4 v[148:151], v113, s[48:51], s54 offen offset:16 sc1
    buffer_load_dwordx4 v[152:155], v114, s[48:51], s55 offen sc1
L_pbd_o0:
    s_cbranch_execz L_lo_16
    s_waitcnt vmcnt(6)
L_lo_16:
    v_xor_b32 v116, v8, v108
    v_xor_b32 v117, v9, v109
    v_xor_b32 v118, v10, v110
    v_xor_b32 v119, v11, v111
    v_xor_b32 v120, v12, v108
    v_xor_b32 v121, v13, v109
    v_xor_b32 v122, v14, v110
    v_xor_b32 v123, v15, v111
    v_xor_b32 v124, v16, v108
    v_xor_b32 v125, v17, v109
    v_xor_b32 v126, v18, v110
    v_xor_b32 v127, v19, v111
    v_or3_b32 v156, v116, v117, v118
    v_or3_b32 v157, v119, v120, v121
    v_or3_b32 v158, v122, v123, v124
    v_or3_b32 v159, v125, v126, v127
    v_or3_b32 v156, v156, v157, v158
    v_or_b32 v159, v156, v159
    v_and_b32 v159, 0x3ff, v159
    v_cmp_ne_u32 vcc, 0, v159
    s_cbranch_execz L_pbd_o1
    s_cbranch_vccz L_pok_o
    s_mov_b64 exec, vcc
    buffer_load_dwordx4 v[8:11], v113, s[48:51], s54 offen sc1
    buffer_load_dwordx4 v[12:15], v113, s[48:51], s54 offen offset:16 sc1
    buffer_load_dwordx4 v[16:19], v114, s[48:51], s55 offen sc1
L_pbd_o1:
    s_cbranch_execz L_lo_17
    s_waitcnt vmcnt(6)
L_lo_17:
    v_xor_b32 v116, v20, v108
    v_xor_b32 v117, v21, v109
    v_xor_b32 v118, v22, v110
    v_xor_b32 v119, v23, v111
    v_xor_b32 v120, v24, v108
    v_xor_b32 v121, v25, v109
    v_xor_b32 v122, v26, v110
    v_xor_b32 v123, v27, v111
    v_xor_b32 v124, v28, v108
    v_xor_b32 v125, v29, v109
    v_xor_b32 v126, v30, v110
    v_xor_b32 v127, v31, v111
    v_or3_b32 v156, v116, v117, v118
    v_or3_b32 v157, v119, v120, v121
    v_or3_b32 v158, v122, v123, v124
    v_or3_b32 v159, v125, v126, v127
    v_or3_b32 v156, v156, v157, v158
    v_or_b32 v159, v156, v159
    v_and_b32 v159, 0x3ff, v159
    v_cmp_ne_u32 vcc, 0, v159
    s_cbranch_execz L_pbd_o2
    s_cbranch_vccz L_pok_o
    s_mov_b64 exec, vcc
    buffer_load_dwordx4 v[20:23], v113, s[48:51], s54 offen sc1
    buffer_load_dwordx4 v[24:27], v113, s[48:51], s54 offen offset:16 sc1
    buffer_load_dwordx4 v[28:31], v114, s[48:51], s55 offen sc1
L_pbd_o2:
    s_cbranch_execz L_pok_o
    s_sub_u32 s60, s60, 1
    s_cmp_lg_u32 s60, 0
    s_cbranch_scc1 L_pb_o
L_pok_o:
    s_mov_b64 exec, s[96:97]
    v_add_f32 v128, v124, v125
    s_nop 1
    v_mov_b32_dpp v129, v128 row_ror:8 row_mask:0xf bank_mask:0xf
    v_sub_f32 v129, v129, v128
    v_exp_f32 v129, v129
    s_nop 0
    v_add_f32 v129, 1.0, v129
    v_rcp_f32 v129, v129
    s_nop 0
    v_mul_f32 v116, v129, v116
    v_mul_f32 v117, v129, v117
    v_mul_f32 v118, v129, v118
    v_mul_f32 v119, v129, v119
    v_mul_f32 v120, v129, v120
    v_mul_f32 v121, v129, v121
    v_mul_f32 v122, v129, v122
    v_mul_f32 v123, v129, v123
    v_add_f32_dpp v156, v116, v116 row_ror:8 row_mask:0xf bank_mask:0xf
    v_add_f32_dpp v157, v117, v117 row_ror:8 row_mask:0xf bank_mask:0xf
    v_add_f32_dpp v158, v118, v118 row_ror:8 row_mask:0xf bank_mask:0xf
    v_add_f32_dpp v159, v119, v119 row_ror:8 row_mask:0xf bank_mask:0xf
    v_add_f32_dpp v160, v120, v120 row_ror:8 row_mask:0xf bank_mask:0xf
    v_add_f32_dpp v161, v121, v121 row_ror:8 row_mask:0xf bank_mask:0xf
    v_add_f32_dpp v162, v122, v122 row_ror:8 row_mask:0xf bank_mask:0xf
    v_add_f32_dpp v163, v123, v123 row_ror:8 row_mask:0xf bank_mask:0xf
    v_cvt_pk_bf16_f32 v40, v156, v157
    v_cvt_pk_bf16_f32 v41, v158, v159
    v_cvt_pk_bf16_f32 v42, v160, v161
    v_cvt_pk_bf16_f32 v43, v162, v163
    s_nop 1
    v_mfma_f32_16x16x32_bf16 v[76:79], v[44:47], v[40:43], 0
    v_mfma_f32_16x16x32_bf16 v[80:83], v[48:51], v[40:43], 0
    v_mfma_f32_16x16x32_bf16 v[84:87], v[52:55], v[40:43], 0
    v_mfma_f32_16x16x32_bf16 v[88:91], v[56:59], v[40:43], 0
    v_mfma_f32_16x16x32_bf16 v[92:95], v[60:63], v[40:43], 0
    v_mfma_f32_16x16x32_bf16 v[96:99], v[64:67], v[40:43], 0
    v_mfma_f32_16x16x32_bf16 v[100:103], v[68:71], v[40:43], 0
    v_mfma_f32_16x16x32_bf16 v[104:107], v[72:75], v[40:43], 0
    s_nop 3
    v_mov_b32 v132, 4
    v_mov_b32 v133, 1
    s_and_b32 exec_lo, s96, 0xff00ff
    s_and_b32 exec_hi, s97, 0xff00ff
    ds_write_b128 v7, v[76:79] offset:0
    ds_write_b128 v7, v[80:83] offset:16
    ds_write_b128 v7, v[84:87] offset:32
    ds_write_b128 v7, v[88:91] offset:48
    ds_write_b128 v7, v[92:95] offset:64
    ds_write_b128 v7, v[96:99] offset:80
    ds_write_b128 v7, v[100:103] offset:96
    ds_write_b128 v7, v[104:107] offset:112
    s_and_b64 exec, s[96:97], 1
    s_waitcnt lgkmcnt(0)
    ds_add_u32 v132, v133
    s_mov_b64 exec, s[96:97]
    s_mov_b32 s60, 1048576
L_lw_18:
    ds_read_b32 v133, v132
    s_waitcnt lgkmcnt(0)
    v_readfirstlane_b32 s61, v133
    s_cbranch_execz L_lwd_19
    s_cmp_ge_u32 s61, 4
    s_cbranch_scc1 L_lwd_19
    s_sub_u32 s60, s60, 1
    s_cmp_lg_u32 s60, 0
    s_cbranch_scc1 L_lw_18
L_lwd_19:
    ds_read_b128 v[116:119], v112 offset:0
    ds_read_b128 v[120:123], v112 offset:4224
    ds_read_b128 v[124:127], v112 offset:8448
    ds_read_b128 v[128:131], v112 offset:12672
    s_waitcnt lgkmcnt(0)
    v_add_f32 v116, v116, v120
    v_add_f32 v124, v124, v128
    v_add_f32 v117, v117, v121
    v_add_f32 v125, v125, v129
    v_add_f32 v118, v118, v122
    v_add_f32 v126, v126, v130
    v_add_f32 v119, v119, v123
    v_add_f32 v127, v127, v131
    v_add_f32 v116, v116, v124
    v_add_f32 v117, v117, v125
    v_add_f32 v118, v118, v126
    v_add_f32 v119, v119, v127
    v_bfi_b32 v116, s64, v116, v108
    v_bfi_b32 v117, s64, v117, v109
    v_bfi_b32 v118, s64, v118, v110
    v_bfi_b32 v119, s64, v119, v111
    s_cbranch_execz L_lo_20
    buffer_store_dwordx4 v[116:119], v134, s[48:51], s53 offen sc1
L_lo_20:
    s_cmp_eq_u32 s6, 0
    s_cbranch_scc1 L_final
    s_cbranch_execz L_po_end
    s_cmp_lg_u32 s99, 0
    s_cbranch_scc1 L_po_end
    s_mov_b64 s[30:31], exec
    s_mov_b64 exec, -1
    s_lshl_b32 s32, s6, 2
    s_add_u32 s32, s32, 48
    v_mov_b32 v137, s32
    s_mov_b32 s60, 1048576
L_lw_21:
    ds_read_b32 v138, v137
    s_waitcnt lgkmcnt(0)
    v_readfirstlane_b32 s61, v138
    s_cbranch_execz L_lwd_22
    s_cmp_ge_u32 s61, 1
    s_cbranch_scc1 L_lwd_22
    s_sleep 1
    s_sub_u32 s60, s60, 1
    s_cmp_lg_u32 s60, 0
    s_cbranch_scc1 L_lw_21
L_lwd_22:
    s_mul_i32 s32, s6, 528
    s_add_u32 s32, s32, 35328
    v_lshlrev_b32 v137, 4, v3
    v_add_u32 v138, s32, v137
    v_mov_b32 v139, s32
    ds_read_b128 v[140:143], v138
    ds_read_b128 v[164:167], v139 offset:512
    s_lshl_b32 s32, s93, 11
    s_lshl_b32 s33, s6, 9
    s_add_u32 s32, s32, s33
    s_add_u32 s32, s32, 9437184
    s_lshl_b32 s34, s93, 6
    s_lshl_b32 s33, s6, 4
    s_add_u32 s34, s34, s33
    s_add_u32 s34, s34, 9961472
    s_waitcnt lgkmcnt(0)
    s_mov_b32 exec_hi, 0
    buffer_store_dwordx4 v[140:143], v137, s[48:51], s32 offen sc1
    s_mov_b64 exec, 1
    buffer_store_dwordx4 v[164:167], v137, s[48:51], s34 offen sc1
    s_mov_b32 s99, 1
L_por_end:
    s_mov_b64 exec, s[30:31]
L_po_end:
    s_cbranch_execz L_hend
    s_cmp_lg_u32 s6, 1
    s_cbranch_scc1 L_hend
    s_cmp_lg_u32 s2, 0
    s_cbranch_scc1 L_hend
    s_load_dwordx2 s[62:63], s[24:25], s65
    s_waitcnt lgkmcnt(0)
    s_add_u32 s62, s62, 1
    s_addc_u32 s63, s63, 0
    v_mov_b32 v60, 0
    s_mov_b64 exec, 1
    s_mov_b32 s60, 1048576
L_epw:
    buffer_load_dword v54, v60, s[40:43], 0 offen sc1
    s_waitcnt vmcnt(0)
    v_readfirstlane_b32 s61, v54
    s_cmp_ge_u32 s61, 256
    s_cbranch_scc1 L_epok
    s_sub_u32 s60, s60, 1
    s_cmp_lg_u32 s60, 0
    s_cbranch_scc1 L_epw
L_epok:
    v_mov_b32 v52, s62
    v_mov_b32 v53, s63
    buffer_store_dwordx2 v[52:53], v60, s[48:51], s65 offen
    s_branch L_hend
L_final:
    s_cbranch_execz L_po_end0
    s_cmp_lg_u32 s99, 0
    s_cbranch_scc1 L_po_end0
    s_mov_b64 s[30:31], exec
    s_mov_b64 exec, -1
    s_lshl_b32 s32, s6, 2
    s_add_u32 s32, s32, 48
    v_mov_b32 v137, s32
    s_mov_b32 s60, 1048576
L_lw_23:
    ds_read_b32 v138, v137
    s_waitcnt lgkmcnt(0)
    v_readfirstlane_b32 s61, v138
    s_cbranch_execz L_lwd_24
    s_cmp_ge_u32 s61, 1
    s_cbranch_scc1 L_lwd_24
    s_sleep 1
    s_sub_u32 s60, s60, 1
    s_cmp_lg_u32 s60, 0
    s_cbranch_scc1 L_lw_23
L_lwd_24:
    s_mul_i32 s32, s6, 528
    s_add_u32 s32, s32, 35328
    v_lshlrev_b32 v137, 4, v3
    v_add_u32 v138, s32, v137
    v_mov_b32 v139, s32
    ds_read_b128 v[140:143], v138
    ds_read_b128 v[164:167], v139 offset:512
    s_lshl_b32 s32, s93, 11
    s_lshl_b32 s33, s6, 9
    s_add_u32 s32, s32, s33
    s_add_u32 s32, s32, 9437184
    s_lshl_b32 s34, s93, 6
    s_lshl_b32 s33, s6, 4
    s_add_u32 s34, s34, s33
    s_add_u32 s34, s34, 9961472
    s_waitcnt lgkmcnt(0)
    s_mov_b32 exec_hi, 0
    buffer_store_dwordx4 v[140:143], v137, s[48:51], s32 offen sc1
    s_mov_b64 exec, 1
    buffer_store_dwordx4 v[164:167], v137, s[48:51], s34 offen sc1
    s_mov_b32 s99, 1
L_por_end0:
    s_mov_b64 exec, s[30:31]
L_po_end0:
    s_mov_b32 s60, 1048576
L_pa_p:
    s_cbranch_execz L_lo_25
    buffer_load_dwordx4 v[8:11], v6, s[48:51], s100 offen offset:0 sc1
    buffer_load_dwordx4 v[12:15], v6, s[48:51], s100 offen offset:1024 sc1
    buffer_load_dwordx4 v[16:19], v6, s[48:51], s100 offen offset:2048 sc1
    buffer_load_dwordx4 v[20:23], v6, s[48:51], s100 offen offset:3072 sc1
    s_waitcnt vmcnt(0)
L_lo_25:
    v_xor_b32 v24, v8, v108
    v_xor_b32 v25, v9, v109
    v_xor_b32 v26, v10, v110
    v_xor_b32 v27, v11, v111
    v_xor_b32 v28, v12, v108
    v_xor_b32 v29, v13, v109
    v_xor_b32 v30, v14, v110
    v_xor_b32 v31, v15, v111
    v_xor_b32 v32, v16, v108
    v_xor_b32 v33, v17, v109
    v_xor_b32 v34, v18, v110
    v_xor_b32 v35, v19, v111
    v_xor_b32 v36, v20, v108
    v_xor_b32 v37, v21, v109
    v_xor_b32 v38, v22, v110
    v_xor_b32 v39, v23, v111
    v_or3_b32 v56, v24, v25, v26
    v_or3_b32 v57, v27, v28, v29
    v_or3_b32 v58, v30, v31, v32
    v_or3_b32 v59, v33, v34, v35
    v_or3_b32 v60, v36, v37, v38
    v_or3_b32 v56, v56, v57, v58
    v_or3_b32 v59, v59, v60, v39
    v_or_b32 v59, v56, v59
    v_and_b32 v59, 0x3ff, v59
    v_cmp_ne_u32 vcc, 0, v59
    s_cbranch_execz L_pbs_p
    s_cbranch_vccz L_pok_p
    s_mov_b64 exec, vcc
    s_bcnt1_i32_b64 s61, vcc
    s_cmp_le_u32 s61, 16
    s_cbranch_scc1 L_pbs_p
    s_sleep 2
    s_sub_u32 s60, s60, 1
    s_cmp_lg_u32 s60, 0
    s_cbranch_scc1 L_pa_p
    s_branch L_pok_p
L_pbs_p:
    s_cbranch_execz L_lo_26
    buffer_load_dwordx4 v[8:11], v6, s[48:51], s100 offen offset:0 sc1
    buffer_load_dwordx4 v[12:15], v6, s[48:51], s100 offen offset:1024 sc1
    buffer_load_dwordx4 v[16:19], v6, s[48:51], s100 offen offset:2048 sc1
    buffer_load_dwordx4 v[20:23], v6, s[48:51], s100 offen offset:3072 sc1
    buffer_load_dwordx4 v[76:79], v6, s[48:51], s100 offen offset:0 sc1
    buffer_load_dwordx4 v[80:83], v6, s[48:51], s100 offen offset:1024 sc1
    buffer_load_dwordx4 v[84:87], v6, s[48:51], s100 offen offset:2048 sc1
    buffer_load_dwordx4 v[88:91], v6, s[48:51], s100 offen offset:3072 sc1
    buffer_load_dwordx4 v[92:95], v6, s[48:51], s100 offen offset:0 sc1
    buffer_load_dwordx4 v[96:99], v6, s[48:51], s100 offen offset:1024 sc1
    buffer_load_dwordx4 v[100:103], v6, s[48:51], s100 offen offset:2048 sc1
    buffer_load_dwordx4 v[104:107], v6, s[48:51], s100 offen offset:3072 sc1
L_lo_26:
L_pb_p:
    s_cbranch_execz L_lo_27
    s_waitcnt vmcnt(8)
L_lo_27:
    v_xor_b32 v24, v8, v108
    v_xor_b32 v25, v9, v109
    v_xor_b32 v26, v10, v110
    v_xor_b32 v27, v11, v111
    v_xor_b32 v28, v12, v108
    v_xor_b32 v29, v13, v109
    v_xor_b32 v30, v14, v110
    v_xor_b32 v31, v15, v111
    v_xor_b32 v32, v16, v108
    v_xor_b32 v33, v17, v109
    v_xor_b32 v34, v18, v110
    v_xor_b32 v35, v19, v111
    v_xor_b32 v36, v20, v108
    v_xor_b32 v37, v21, v109
    v_xor_b32 v38, v22, v110
    v_xor_b32 v39, v23, v111
    v_or3_b32 v56, v24, v25, v26
    v_or3_b32 v57, v27, v28, v29
    v_or3_b32 v58, v30, v31, v32
    v_or3_b32 v59, v33, v34, v35
    v_or3_b32 v60, v36, v37, v38
    v_or3_b32 v56, v56, v57, v58
    v_or3_b32 v59, v59, v60, v39
    v_or_b32 v59, v56, v59
    v_and_b32 v59, 0x3ff, v59
    v_cmp_ne_u32 vcc, 0, v59
    s_cbranch_execz L_pbd_p0
    s_cbranch_vccz L_pok_p
    s_mov_b64 exec, vcc
    buffer_load_dwordx4 v[8:11], v6, s[48:51], s100 offen offset:0 sc1
    buffer_load_dwordx4 v[12:15], v6, s[48:51], s100 offen offset:1024 sc1
    buffer_load_dwordx4 v[16:19], v6, s[48:51], s100 offen offset:2048 sc1
    buffer_load_dwordx4 v[20:23], v6, s[48:51], s100 offen offset:3072 sc1
L_pbd_p0:
    s_cbranch_execz L_lo_28
    s_waitcnt vmcnt(8)
L_lo_28:
    v_xor_b32 v24, v76, v108
    v_xor_b32 v25, v77, v109
    v_xor_b32 v26, v78, v110
    v_xor_b32 v27, v79, v111
    v_xor_b32 v28, v80, v108
    v_xor_b32 v29, v81, v109
    v_xor_b32 v30, v82, v110
    v_xor_b32 v31, v83, v111
    v_xor_b32 v32, v84, v108
    v_xor_b32 v33, v85, v109
    v_xor_b32 v34, v86, v110
    v_xor_b32 v35, v87, v111
    v_xor_b32 v36, v88, v108
    v_xor_b32 v37, v89, v109
    v_xor_b32 v38, v90, v110
    v_xor_b32 v39, v91, v111
    v_or3_b32 v56, v24, v25, v26
    v_or3_b32 v57, v27, v28, v29
    v_or3_b32 v58, v30, v31, v32
    v_or3_b32 v59, v33, v34, v35
    v_or3_b32 v60, v36, v37, v38
    v_or3_b32 v56, v56, v57, v58
    v_or3_b32 v59, v59, v60, v39
    v_or_b32 v59, v56, v59
    v_and_b32 v59, 0x3ff, v59
    v_cmp_ne_u32 vcc, 0, v59
    s_cbranch_execz L_pbd_p1
    s_cbranch_vccz L_pok_p
    s_mov_b64 exec, vcc
    buffer_load_dwordx4 v[76:79], v6, s[48:51], s100 offen offset:0 sc1
    buffer_load_dwordx4 v[80:83], v6, s[48:51], s100 offen offset:1024 sc1
    buffer_load_dwordx4 v[84:87], v6, s[48:51], s100 offen offset:2048 sc1
    buffer_load_dwordx4 v[88:91], v6, s[48:51], s100 offen offset:3072 sc1
L_pbd_p1:
    s_cbranch_execz L_lo_29
    s_waitcnt vmcnt(8)
L_lo_29:
    v_xor_b32 v24, v92, v108
    v_xor_b32 v25, v93, v109
    v_xor_b32 v26, v94, v110
    v_xor_b32 v27, v95, v111
    v_xor_b32 v28, v96, v108
    v_xor_b32 v29, v97, v109
    v_xor_b32 v30, v98, v110
    v_xor_b32 v31, v99, v111
    v_xor_b32 v32, v100, v108
    v_xor_b32 v33, v101, v109
    v_xor_b32 v34, v102, v110
    v_xor_b32 v35, v103, v111
    v_xor_b32 v36, v104, v108
    v_xor_b32 v37, v105, v109
    v_xor_b32 v38, v106, v110
    v_xor_b32 v39, v107, v111
    v_or3_b32 v56, v24, v25, v26
    v_or3_b32 v57, v27, v28, v29
    v_or3_b32 v58, v30, v31, v32
    v_or3_b32 v59, v33, v34, v35
    v_or3_b32 v60, v36, v37, v38
    v_or3_b32 v56, v56, v57, v58
    v_or3_b32 v59, v59, v60, v39
    v_or_b32 v59, v56, v59
    v_and_b32 v59, 0x3ff, v59
    v_cmp_ne_u32 vcc, 0, v59
    s_cbranch_execz L_pbd_p2
    s_cbranch_vccz L_pok_p
    s_mov_b64 exec, vcc
    buffer_load_dwordx4 v[92:95], v6, s[48:51], s100 offen offset:0 sc1
    buffer_load_dwordx4 v[96:99], v6, s[48:51], s100 offen offset:1024 sc1
    buffer_load_dwordx4 v[100:103], v6, s[48:51], s100 offen offset:2048 sc1
    buffer_load_dwordx4 v[104:107], v6, s[48:51], s100 offen offset:3072 sc1
L_pbd_p2:
    s_cbranch_execz L_pok_p
    s_sub_u32 s60, s60, 1
    s_cmp_lg_u32 s60, 0
    s_cbranch_scc1 L_pb_p
L_pok_p:
    s_mov_b64 exec, s[96:97]
    v_add_f32 v44, v24, v28
    v_add_f32 v48, v32, v36
    v_add_f32 v45, v25, v29
    v_add_f32 v49, v33, v37
    v_add_f32 v46, v26, v30
    v_add_f32 v50, v34, v38
    v_add_f32 v47, v27, v31
    v_add_f32 v51, v35, v39
    v_add_f32 v44, v44, v48
    v_add_f32 v45, v45, v49
    v_add_f32 v46, v46, v50
    v_add_f32 v47, v47, v51
    s_nop 1
    v_add_f32_dpp v48, v44, v44 row_ror:8 row_mask:0xf bank_mask:0xf
    v_add_f32_dpp v49, v45, v45 row_ror:8 row_mask:0xf bank_mask:0xf
    v_add_f32_dpp v50, v46, v46 row_ror:8 row_mask:0xf bank_mask:0xf
    v_add_f32_dpp v51, v47, v47 row_ror:8 row_mask:0xf bank_mask:0xf
    v_mov_b32 v44, v48
    v_mov_b32 v45, v49
    v_mov_b32 v46, v50
    v_mov_b32 v47, v51
    s_nop 1
    v_permlane16_swap_b32 v44, v48
    v_permlane16_swap_b32 v45, v49
    v_permlane16_swap_b32 v46, v50
    v_permlane16_swap_b32 v47, v51
    s_nop 1
    v_add_f32 v48, v44, v48
    v_add_f32 v49, v45, v49
    v_add_f32 v50, v46, v50
    v_add_f32 v51, v47, v51
    v_mov_b32 v44, v48
    v_mov_b32 v45, v49
    v_mov_b32 v46, v50
    v_mov_b32 v47, v51
    s_nop 1
    v_permlane32_swap_b32 v44, v48
    v_permlane32_swap_b32 v45, v49
    v_permlane32_swap_b32 v46, v50
    v_permlane32_swap_b32 v47, v51
    s_nop 1
    v_add_f32 v48, v44, v48
    v_add_f32 v49, v45, v49
    v_add_f32 v50, v46, v50
    v_add_f32 v51, v47, v51
    v_cndmask_b32 v48, v48, v49, s[8:9]
    v_cndmask_b32 v48, v48, v50, s[10:11]
    v_cndmask_b32 v48, v48, v51, s[12:13]
    v_cvt_pk_bf16_f32 v48, v48, v48
    s_mov_b32 exec_hi, 0
    s_cbranch_execz L_lo_30
    buffer_store_short v48, v135, s[44:47], s101 offen
L_lo_30:
L_hend:
    s_cbranch_execnz L_hexit
    s_mov_b64 s[96:97], -1
    s_mov_b64 exec, -1
    s_branch L_tail
L_hexit:
L_end:
    s_endpgm
.section .rodata,"a"
.p2align 6
.amdhsa_kernel concat_heads__sliding_block_cached__sliding_block_cached__decode_kernel
  .amdhsa_next_free_vgpr 168
  .amdhsa_next_free_sgpr 102
  .amdhsa_accum_offset 168
  .amdhsa_group_segment_fixed_size 0
  .amdhsa_kernarg_size 104
  .amdhsa_user_sgpr_count 2
  .amdhsa_user_sgpr_kernarg_segment_ptr 1
  .amdhsa_system_sgpr_workgroup_id_x 1
.end_amdhsa_kernel
```
